```python
import torch

def _softmax(x, axis=-1):
    return torch.softmax(x, dim=axis)
def _gelu(x):
    return torch.nn.functional.gelu(x, approximate="tanh")
def _silu(x):
    return torch.nn.functional.silu(x)
def _sigmoid(x):
    return torch.sigmoid(x)
def _layernorm(x, axis=-1, eps=1e-5):
    m = x.mean(dim=axis, keepdim=True)
    v = x.var(dim=axis, keepdim=True, unbiased=False)
    return (x - m) / torch.sqrt(v + eps)
def _scatter_add(tgt, idx, src, axis=0):
    return tgt.clone().index_add_(axis, idx, src)
def _segment_sum(src, seg, n):
    out = torch.zeros((n,) + src.shape[1:], dtype=src.dtype)
    return out.index_add_(0, seg, src)
def _pad(x, pw):
    flat = tuple(v for pair in reversed(pw) for v in pair)
    return torch.nn.functional.pad(x, flat)

kernel_name = 'standalone__edge_featured_mpnn_gatedgcn__graph'

def setup_inputs():

    _w = (lambda a: (lambda t: t.to(torch.bfloat16) if t.is_floating_point() else t)(torch.as_tensor(a)))
    N, deg, D, De = 10000, 64, 64, max(4, 1)
    E = N * deg
    return {
        "x": _w((lambda *s: torch.randn(*s, dtype=torch.bfloat16) * 0.8)(N, D)),
        "e_attr": _w((lambda *s: torch.randn(*s, dtype=torch.bfloat16) * 0.8)(E, De)),
        "src": _w((lambda lo, hi, *s: torch.randint(lo, hi, s))(0, N, E).to(torch.int64)),
        "dst": _w((lambda lo, hi, *s: torch.randint(lo, hi, s))(0, N, E).to(torch.int64)),
        "w_a": _w((lambda *s: torch.randn(*s, dtype=torch.bfloat16) * 0.8)(D, D)),
        "w_b": _w((lambda *s: torch.randn(*s, dtype=torch.bfloat16) * 0.8)(D, D)),
        "w_c": _w((lambda *s: torch.randn(*s, dtype=torch.bfloat16) * 0.8)(De, D)),
        "w_u": _w((lambda *s: torch.randn(*s, dtype=torch.bfloat16) * 0.05)(D, D)),
        "w_v": _w((lambda *s: torch.randn(*s, dtype=torch.bfloat16) * 0.05)(D, D)),
    }

def reference(x, e_attr, src, dst, w_a, w_b, w_c, w_u, w_v):
    N, D = x.shape
    hv = x @ w_v
    g = x[dst] @ w_a + x[src] @ w_b + e_attr @ w_c
    eta = _sigmoid(g)
    denom = _segment_sum(eta, dst, N) + 1e-6
    eta_n = eta / denom[dst]
    agg = _segment_sum(eta_n * hv[src], dst, N)
    z = x @ w_u + agg
    relu_z = torch.where(z > 0, z, 0 * z)
    return x + relu_z
```

```asm
; @launch grid=(250,1,1) block=(1024,1,1) lds=156800
.amdgcn_target "amdgcn-amd-amdhsa--gfx950"
.text

.globl standalone__edge_featured_mpnn_gatedgcn__graph_kernel
.p2align 8
.type standalone__edge_featured_mpnn_gatedgcn__graph_kernel,@function
standalone__edge_featured_mpnn_gatedgcn__graph_kernel:
    s_cmp_ge_u32 s2, 250
    s_cbranch_scc1 L_END
    s_load_dwordx16 s[4:19], s[0:1], 0
    s_load_dwordx8 s[20:27], s[0:1], 64
    v_lshrrev_b32 v1, 6, v0
    v_and_b32 v127, 63, v0
    v_readfirstlane_b32 s3, v1
    v_lshrrev_b32 v126, 4, v127
    v_and_b32 v125, 15, v127
    v_lshlrev_b32 v93, 4, v125
    v_mov_b32 v95, v93
    v_and_b32 v2, 3, v125
    v_lshrrev_b32 v3, 2, v125
    v_cmp_eq_u32 vcc, v2, v126
    v_lshlrev_b32 v4, 3, v3
    v_add_u32 v4, 89728, v4
    v_mov_b32 v5, 28928
    v_cndmask_b32 v120, v5, v4, vcc
    v_mov_b32 v5, 32
    v_cndmask_b32 v121, 0, v5, vcc
    v_lshlrev_b32 v90, 3, v121
    v_cmp_eq_u32 vcc, v3, v126
    v_mov_b32 v5, 0x3f80
    v_lshrrev_b32 v6, 1, v2
    v_lshlrev_b32 v6, 4, v6
    v_lshlrev_b32 v5, v6, v5
    v_cndmask_b32 v5, 0, v5, vcc
    v_and_b32 v6, 1, v2
    v_cmp_eq_u32 vcc, 0, v6
    v_lshlrev_b32 v91, 4, v125
    v_add_u32 v91, 30080, v91
    v_cndmask_b32 v102, 0, v5, vcc
    v_cndmask_b32 v103, v5, 0, vcc
    v_mov_b32 v106, v102
    v_mov_b32 v107, v103
    v_lshlrev_b32 v123, 3, v127
    v_lshlrev_b32 v122, 2, v126
    v_add_u32 v122, 56192, v122
    s_mov_b32 s68, 0
    s_mov_b32 s78, 0x21800000
    s_mov_b32 s79, 0x21800000
    s_cmp_eq_u32 s3, 15
    s_cselect_b32 s65, 0xffff0000, 0
    s_cselect_b32 s67, -1, 0
    s_mov_b32 s64, 0
    s_mov_b32 s66, 0
    s_cmp_ge_u32 s3, 10
    s_cbranch_scc1 L_TABLE
    s_mul_i32 s30, s2, 10240
    v_lshlrev_b32 v2, 4, v0
    v_add_u32 v3, s30, v2
    s_lshl_b32 s31, s30, 1
    v_lshlrev_b32 v4, 5, v0
    v_add_u32 v4, s31, v4
    s_mul_i32 s32, s2, 5120
    v_add_u32 v64, s32, v2
    v_mov_b32 v6, 0
    v_lshlrev_b32 v7, 2, v0
    s_waitcnt lgkmcnt(0)
    global_load_dwordx4 v[8:11], v3, s[10:11]
    s_load_dwordx2 s[28:29], s[26:27], 0
    s_cmp_ge_u32 s3, 4
    s_cbranch_scc1 L_NOZH
    ds_write_b32 v7, v6 offset:56192
L_NOZH:
    s_cmp_lg_u32 s3, 4
    s_cbranch_scc1 L_NOZC
    v_mov_b32 v32, 0
    v_mov_b32 v33, 0
    v_mov_b32 v34, 0
    v_mov_b32 v35, 0
    v_lshlrev_b32 v36, 4, v127
    v_cmp_gt_u32 vcc, 49, v127
    s_and_saveexec_b64 s[34:35], vcc
    ds_write_b128 v36, v[32:35] offset:28672
    s_mov_b64 exec, s[34:35]
L_NOZC:
    s_add_u32 s40, s26, 3801088
    s_addc_u32 s41, s27, 0
    s_mov_b32 s42, 7712000
    s_mov_b32 s43, 0x20000
    s_add_u32 s44, s26, 4096
    s_addc_u32 s45, s27, 0
    s_or_b32 s45, s45, 0x01000000
    s_mov_b32 s46, 10001
    s_mov_b32 s47, 0x20000
    s_and_b32 s30, s2, 7
    s_lshl_b32 s30, s30, 5
    s_lshr_b32 s31, s2, 3
    s_or_b32 s31, s30, s31
    s_lshr_b32 s30, s31, 3
    s_mul_i32 s30, s30, 33152
    s_and_b32 s31, s31, 7
    s_lshl_b32 s31, s31, 4
    s_add_u32 s30, s30, s31
    s_lshl_b32 s31, s3, 11
    s_add_u32 s30, s30, s31
    s_add_u32 s30, s30, 2621440
    v_lshl_add_u32 v96, v126, 9, s30
    s_lshl_b32 s30, s3, 8
    s_add_u32 s30, s30, 2572288
    v_lshl_add_u32 v97, v125, 4, s30
    v_mov_b32 v98, 1
    v_lshlrev_b32 v99, 2, v127
    s_mul_i32 s36, s2, 30848
    s_mov_b32 s38, 58240
    v_lshl_add_u32 v56, v0, 4, s38
    v_mad_u32_u24 v57, v0, 12, s36
    v_add_u32 v58, 7680, v57
    v_add_u32 v59, 15360, v57
    v_add_u32 v60, 23040, v57
    s_and_b32 s37, s3, 3
    s_lshl_b32 s30, s37, 8
    v_lshl_add_u32 v61, v127, 2, s30
    s_mul_i32 s37, s37, 265216
    s_lshl_b32 s30, s2, 7
    s_add_u32 s37, s37, s30
    s_add_u32 s37, s37, 2621440
    v_lshrrev_b32 v62, 3, v127
    v_mul_u32_u24 v62, 33152, v62
    v_add_u32 v62, s37, v62
    v_and_b32 v63, 7, v127
    v_lshl_add_u32 v62, v63, 4, v62
    v_lshlrev_b32 v63, 4, v127
    s_mov_b32 s33, 52429
    s_movk_i32 s34, 0xffd8
    s_movk_i32 s37, 0xfc04
    global_load_dwordx4 v[12:15], v3, s[8:9]
    global_load_dwordx4 v[16:19], v4, s[6:7]
    global_load_dwordx4 v[24:27], v4, s[6:7] offset:16
    s_waitcnt lgkmcnt(0)
    s_add_u32 s28, s28, 1
    s_addc_u32 s29, s29, 0
    v_mov_b32 v53, s28
    v_mov_b32 v54, s29
    v_mov_b32 v55, s28
    s_barrier
    s_waitcnt vmcnt(3)
    v_mul_u32_u24 v40, s33, v8
    v_lshrrev_b32 v32, 21, v40
    v_lshrrev_b32 v40, 24, v40
    v_mad_i32_i24 v8, v32, s34, v8
    v_lshlrev_b32 v32, 7, v32
    v_mad_i32_i24 v32, v40, s37, v32
    ds_add_rtn_u32 v36, v32, v98 offset:56192
    v_mul_u32_u24 v41, s33, v9
    v_lshrrev_b32 v33, 21, v41
    v_lshrrev_b32 v41, 24, v41
    v_mad_i32_i24 v9, v33, s34, v9
    v_lshlrev_b32 v33, 7, v33
    v_mad_i32_i24 v33, v41, s37, v33
    ds_add_rtn_u32 v37, v33, v98 offset:56192
    v_mul_u32_u24 v42, s33, v10
    v_lshrrev_b32 v34, 21, v42
    v_lshrrev_b32 v42, 24, v42
    v_mad_i32_i24 v10, v34, s34, v10
    v_lshlrev_b32 v34, 7, v34
    v_mad_i32_i24 v34, v42, s37, v34
    ds_add_rtn_u32 v38, v34, v98 offset:56192
    v_mul_u32_u24 v43, s33, v11
    v_lshrrev_b32 v35, 21, v43
    v_lshrrev_b32 v43, 24, v43
    v_mad_i32_i24 v11, v35, s34, v11
    v_lshlrev_b32 v35, 7, v35
    v_mad_i32_i24 v35, v43, s37, v35
    ds_add_rtn_u32 v39, v35, v98 offset:56192
    v_lshlrev_b32 v8, 2, v8
    v_lshlrev_b32 v9, 2, v9
    v_lshlrev_b32 v10, 2, v10
    v_lshlrev_b32 v11, 2, v11
    s_waitcnt lgkmcnt(0)
    s_barrier
    ds_read_b128 v[40:43], v63 offset:56192
    s_waitcnt lgkmcnt(0)
    v_add_u32 v44, v40, v41
    v_add_u32 v45, v44, v42
    v_add_u32 v46, v45, v43
    v_mov_b32 v47, v46
    s_nop 1
    v_add_u32_dpp v47, v47, v47 row_shr:1 row_mask:0xf bank_mask:0xf bound_ctrl:0
    s_nop 1
    v_add_u32_dpp v47, v47, v47 row_shr:2 row_mask:0xf bank_mask:0xf bound_ctrl:0
    s_nop 1
    v_add_u32_dpp v47, v47, v47 row_shr:4 row_mask:0xf bank_mask:0xf bound_ctrl:0
    s_nop 1
    v_add_u32_dpp v47, v47, v47 row_shr:8 row_mask:0xf bank_mask:0xf bound_ctrl:0
    s_nop 1
    v_add_u32_dpp v47, v47, v47 row_bcast:15 row_mask:0xa bank_mask:0xf
    s_nop 1
    v_add_u32_dpp v47, v47, v47 row_bcast:31 row_mask:0xc bank_mask:0xf
    s_nop 1
    v_sub_u32 v48, v47, v46
    v_add_u32 v49, v48, v40
    v_add_u32 v50, v48, v44
    v_add_u32 v51, v48, v45
    ds_write_b128 v63, v[48:51] offset:57216
    s_waitcnt vmcnt(0)
    v_lshl_or_b32 v12, v12, 8, v8
    v_lshl_or_b32 v13, v13, 8, v9
    v_lshl_or_b32 v14, v14, 8, v10
    v_lshl_or_b32 v15, v15, 8, v11
    v_pk_mov_b32 v[20:21], v[18:19], v[18:19] op_sel:[0,1]
    v_pk_mov_b32 v[28:29], v[26:27], v[26:27] op_sel:[0,1]
    v_mov_b32 v18, v12
    v_mov_b32 v22, v13
    v_mov_b32 v26, v14
    v_mov_b32 v30, v15
    s_waitcnt lgkmcnt(0)
    ds_read_b32 v44, v32 offset:57216
    ds_read_b32 v45, v33 offset:57216
    ds_read_b32 v46, v34 offset:57216
    ds_read_b32 v47, v35 offset:57216
    ds_read_b32 v52, v61 offset:57216
    ds_read_b32 v48, v61 offset:56192
    s_waitcnt lgkmcnt(2)
    v_add_u32 v44, v44, v36
    v_lshl_add_u32 v44, v44, 4, s38
    ds_write_b128 v44, v[16:19]
    v_add_u32 v45, v45, v37
    v_lshl_add_u32 v45, v45, 4, s38
    ds_write_b128 v45, v[20:23]
    v_add_u32 v46, v46, v38
    v_lshl_add_u32 v46, v46, 4, s38
    ds_write_b128 v46, v[24:27]
    v_add_u32 v47, v47, v39
    v_lshl_add_u32 v47, v47, 4, s38
    ds_write_b128 v47, v[28:31]
    s_add_u32 s30, s26, 3801088
    s_addc_u32 s31, s27, 0
    s_waitcnt lgkmcnt(0)
    s_barrier
    ds_read_b96 v[32:34], v56 offset:0
    ds_read_b96 v[36:38], v56 offset:10240
    ds_read_b96 v[40:42], v56 offset:20480
    ds_read_b96 v[44:46], v56 offset:30720
    v_lshl_or_b32 v52, v48, 20, v52
    s_waitcnt lgkmcnt(3)
    global_store_dwordx3 v57, v[32:34], s[30:31] sc1
    s_waitcnt lgkmcnt(2)
    global_store_dwordx3 v58, v[36:38], s[30:31] sc1
    s_waitcnt lgkmcnt(1)
    global_store_dwordx3 v59, v[40:42], s[30:31] sc1
    s_waitcnt lgkmcnt(0)
    global_store_dwordx3 v60, v[44:46], s[30:31] sc1
    s_cmp_ge_u32 s3, 5
    s_cbranch_scc1 L_NOXR
    global_load_dwordx4 v[112:115], v64, s[4:5]
L_NOXR:
    s_waitcnt vmcnt(0)
    s_barrier
    s_cmp_ge_u32 s3, 4
    s_cbranch_scc1 L_PHASEB
    global_store_dwordx4 v62, v[52:55], s[26:27] sc1
    s_branch L_PHASEB
L_TABLE:
    s_sub_u32 s36, s3, 10
    s_and_b32 s37, s36, 1
    s_add_u32 s38, s37, 6
    v_lshlrev_b32 v2, 4, v127
    s_lshl_b32 s30, s36, 10
    v_add_u32 v3, s30, v2
    s_lshl_b32 s31, s38, 10
    v_add_u32 v4, s31, v2
    s_mul_i32 s32, s2, 5120
    v_add_u32 v5, s32, v3
    v_lshrrev_b32 v6, 3, v127
    v_mul_u32_u24 v6, 144, v6
    v_and_b32 v7, 7, v127
    v_lshl_add_u32 v6, v7, 4, v6
    s_mul_i32 s33, s36, 1152
    s_add_u32 s33, s33, 99200
    v_add_u32 v48, s33, v6
    s_mul_i32 s33, s38, 1152
    s_add_u32 s33, s33, 99200
    v_add_u32 v49, s33, v6
    v_lshrrev_b32 v50, 1, v126
    v_and_b32 v51, 1, v126
    v_lshl_or_b32 v50, v51, 1, v50
    v_lshl_add_u32 v50, v125, 2, v50
    v_lshlrev_b32 v50, 1, v50
    s_waitcnt lgkmcnt(0)
    s_load_dwordx2 s[28:29], s[26:27], 0
    s_add_u32 s40, s26, 3801088
    s_addc_u32 s41, s27, 0
    s_mov_b32 s42, 7712000
    s_mov_b32 s43, 0x20000
    s_add_u32 s44, s26, 4096
    s_addc_u32 s45, s27, 0
    s_or_b32 s45, s45, 0x01000000
    s_mov_b32 s46, 10001
    s_mov_b32 s47, 0x20000
    s_and_b32 s30, s2, 7
    s_lshl_b32 s30, s30, 5
    s_lshr_b32 s31, s2, 3
    s_or_b32 s31, s30, s31
    s_lshr_b32 s30, s31, 3
    s_mul_i32 s30, s30, 33152
    s_and_b32 s31, s31, 7
    s_lshl_b32 s31, s31, 4
    s_add_u32 s30, s30, s31
    s_lshl_b32 s31, s3, 11
    s_add_u32 s30, s30, s31
    s_add_u32 s30, s30, 2621440
    v_lshl_add_u32 v96, v126, 9, s30
    s_lshl_b32 s30, s3, 8
    s_add_u32 s30, s30, 2572288
    v_lshl_add_u32 v97, v125, 4, s30
    v_mov_b32 v98, 1
    v_lshlrev_b32 v99, 2, v127
    s_barrier
    global_load_dwordx4 v[8:11], v3, s[14:15]
    global_load_dwordx4 v[12:15], v4, s[14:15]
    global_load_dwordx4 v[16:19], v3, s[20:21]
    global_load_dwordx4 v[20:23], v4, s[20:21]
    global_load_dwordx4 v[24:27], v3, s[12:13]
    global_load_dwordx4 v[28:31], v4, s[12:13]
    global_load_dwordx4 v[32:35], v3, s[18:19]
    global_load_dwordx4 v[36:39], v4, s[18:19]
    s_cmp_eq_u32 s36, 5
    s_cbranch_scc1 L_TWC0
    global_load_dwordx4 v[40:43], v5, s[4:5]
    s_branch L_TB
L_TWC0:
    global_load_ushort v40, v50, s[16:17]
    global_load_ushort v41, v50, s[16:17] offset:128
    global_load_ushort v42, v50, s[16:17] offset:256
    global_load_ushort v43, v50, s[16:17] offset:384
L_TB:
    s_barrier
    s_barrier
    s_cmp_eq_u32 s36, 5
    s_cbranch_scc1 L_TWC
    s_waitcnt vmcnt(0)
    ds_write_b128 v48, v[40:43] offset:36864
    s_branch L_TST
L_TWC:
    s_mov_b32 s33, 0xbfb8aa3b
    v_lshlrev_b32 v44, 3, v127
    s_waitcnt vmcnt(0)
    v_lshlrev_b32 v40, 16, v40
    v_lshlrev_b32 v41, 16, v41
    v_lshlrev_b32 v42, 16, v42
    v_lshlrev_b32 v43, 16, v43
    v_mul_f32 v40, s33, v40
    v_mul_f32 v41, s33, v41
    v_mul_f32 v42, s33, v42
    v_mul_f32 v43, s33, v43
    v_cvt_pk_bf16_f32 v40, v40, v41
    v_cvt_pk_bf16_f32 v41, v42, v43
    ds_write_b64 v44, v[40:41] offset:29504
L_TST:
    ds_write_b128 v48, v[8:11] offset:0
    ds_write_b128 v49, v[12:15] offset:0
    ds_write_b128 v48, v[16:19] offset:9216
    ds_write_b128 v49, v[20:23] offset:9216
    ds_write_b128 v48, v[24:27] offset:18432
    ds_write_b128 v49, v[28:31] offset:18432
    ds_write_b128 v48, v[32:35] offset:27648
    ds_write_b128 v49, v[36:39] offset:27648
    s_lshr_b32 s30, s36, 1
    s_lshl_b32 s31, s37, 1
    s_lshl_b32 s32, s30, 4
    v_add_u32 v4, s32, v125
    v_mul_u32_u24 v5, 144, v4
    v_lshl_add_u32 v5, v126, 4, v5
    v_add_u32 v5, 136064, v5
    v_lshrrev_b32 v6, 2, v125
    v_lshl_add_u32 v6, v126, 3, v6
    v_mul_u32_u24 v6, 144, v6
    v_and_b32 v7, 3, v125
    v_lshl_add_u32 v6, v7, 3, v6
    s_lshl_b32 s32, s31, 5
    s_add_u32 s32, s32, 99200
    v_add_u32 v6, s32, v6
    v_mul_u32_u24 v7, 272, v4
    v_lshl_add_u32 v50, v126, 4, v7
    s_lshl_b32 s32, s31, 6
    v_add_u32 v50, s32, v50
    v_add_u32 v51, 30080, v50
    v_add_u32 v53, 43136, v50
    s_waitcnt lgkmcnt(0)
    s_add_u32 s28, s28, 1
    s_addc_u32 s29, s29, 0

    v_mov_b32 v54, 29448
    v_mov_b32 v55, 1
    s_mov_b64 exec, 1
    ds_add_u32 v54, v55
    s_mov_b64 exec, -1
    s_mov_b32 s33, 0
L_TSYNC:
    ds_read_b32 v55, v54
    s_add_u32 s33, s33, 1
    s_cmp_ge_u32 s33, 1048576
    s_cbranch_scc1 L_END
    s_waitcnt lgkmcnt(0)
    v_readfirstlane_b32 s30, v55
    s_nop 3
    s_cmp_lt_u32 s30, 6
    s_cbranch_scc1 L_TSYNC

    ds_read_b128 v[8:11], v5
    ds_read_b128 v[12:15], v5 offset:64
    ds_read_b64_tr_b16 v[16:17], v6 offset:0
    ds_read_b64_tr_b16 v[18:19], v6 offset:576
    ds_read_b64_tr_b16 v[20:21], v6 offset:4608
    ds_read_b64_tr_b16 v[22:23], v6 offset:5184
    ds_read_b64_tr_b16 v[24:25], v6 offset:9216
    ds_read_b64_tr_b16 v[26:27], v6 offset:9792
    ds_read_b64_tr_b16 v[28:29], v6 offset:13824
    ds_read_b64_tr_b16 v[30:31], v6 offset:14400
    ds_read_b64_tr_b16 v[32:33], v6 offset:32
    ds_read_b64_tr_b16 v[34:35], v6 offset:608
    ds_read_b64_tr_b16 v[36:37], v6 offset:4640
    ds_read_b64_tr_b16 v[38:39], v6 offset:5216
    ds_read_b64_tr_b16 v[40:41], v6 offset:9248
    ds_read_b64_tr_b16 v[42:43], v6 offset:9824
    ds_read_b64_tr_b16 v[44:45], v6 offset:13856
    ds_read_b64_tr_b16 v[46:47], v6 offset:14432
    s_mul_i32 s31, s2, 10240
    s_add_u32 s31, s31, 4096
    v_lshlrev_b32 v55, 8, v4
    v_add_u32 v55, s31, v55
    v_lshl_add_u32 v55, v126, 4, v55
    s_and_b32 s30, s36, 1
    s_lshl_b32 s30, s30, 7
    v_add_u32 v55, s30, v55
    v_cmp_gt_u32 s[34:35], 40, v4
    s_mov_b32 s32, 0xbfb8aa3b
    s_mov_b32 s33, 0x71800000
    v_mov_b32 v54, 0xf1800000
    s_waitcnt lgkmcnt(0)
    v_mfma_f32_16x16x32_bf16 v[56:59], v[16:19], v[8:11], 0
    v_mfma_f32_16x16x32_bf16 v[56:59], v[20:23], v[12:15], v[56:59]
    v_mfma_f32_16x16x32_bf16 v[60:63], v[24:27], v[8:11], 0
    v_mfma_f32_16x16x32_bf16 v[60:63], v[28:31], v[12:15], v[60:63]
    v_mfma_f32_16x16x32_bf16 v[64:67], v[32:35], v[8:11], 0
    v_mfma_f32_16x16x32_bf16 v[64:67], v[36:39], v[12:15], v[64:67]
    v_mfma_f32_16x16x32_bf16 v[68:71], v[40:43], v[8:11], 0
    v_mfma_f32_16x16x32_bf16 v[68:71], v[44:47], v[12:15], v[68:71]
    ds_read_b64_tr_b16 v[16:17], v6 offset:18432
    ds_read_b64_tr_b16 v[18:19], v6 offset:19008
    ds_read_b64_tr_b16 v[20:21], v6 offset:23040
    ds_read_b64_tr_b16 v[22:23], v6 offset:23616
    ds_read_b64_tr_b16 v[24:25], v6 offset:27648
    ds_read_b64_tr_b16 v[26:27], v6 offset:28224
    ds_read_b64_tr_b16 v[28:29], v6 offset:32256
    ds_read_b64_tr_b16 v[30:31], v6 offset:32832
    ds_read_b64_tr_b16 v[32:33], v6 offset:18464
    ds_read_b64_tr_b16 v[34:35], v6 offset:19040
    ds_read_b64_tr_b16 v[36:37], v6 offset:23072
    ds_read_b64_tr_b16 v[38:39], v6 offset:23648
    ds_read_b64_tr_b16 v[40:41], v6 offset:27680
    ds_read_b64_tr_b16 v[42:43], v6 offset:28256
    ds_read_b64_tr_b16 v[44:45], v6 offset:32288
    ds_read_b64_tr_b16 v[46:47], v6 offset:32864
    s_mov_b32 s30, 0x8000
    v_mul_f32 v56, s32, v56
    v_med3_f32 v56, v56, v54, s33
    v_mul_f32 v57, s32, v57
    v_med3_f32 v57, v57, v54, s33
    v_mul_f32 v58, s32, v58
    v_med3_f32 v58, v58, v54, s33
    v_mul_f32 v59, s32, v59
    v_med3_f32 v59, v59, v54, s33
    v_cvt_pk_bf16_f32 v72, v56, v57
    v_cvt_pk_bf16_f32 v73, v58, v59
    v_cvt_pk_bf16_f32 v80, v60, v60
    v_and_b32 v80, 0xffff, v80
    v_and_b32 v81, 0x7fffffff, v61
    v_and_b32 v61, 0x80000000, v61
    v_sub_u32 v81, v81, v80
    v_add_u32 v81, s30, v81
    v_max_i32 v81, 0, v81
    v_and_b32 v81, 0xffff0000, v81
    v_or3_b32 v74, v81, v80, v61
    v_cvt_pk_bf16_f32 v80, v62, v62
    v_and_b32 v80, 0xffff, v80
    v_and_b32 v81, 0x7fffffff, v63
    v_and_b32 v63, 0x80000000, v63
    v_sub_u32 v81, v81, v80
    v_add_u32 v81, s30, v81
    v_max_i32 v81, 0, v81
    v_and_b32 v81, 0xffff0000, v81
    v_or3_b32 v75, v81, v80, v63
    v_mul_f32 v64, s32, v64
    v_med3_f32 v64, v64, v54, s33
    v_mul_f32 v65, s32, v65
    v_med3_f32 v65, v65, v54, s33
    v_mul_f32 v66, s32, v66
    v_med3_f32 v66, v66, v54, s33
    v_mul_f32 v67, s32, v67
    v_med3_f32 v67, v67, v54, s33
    v_cvt_pk_bf16_f32 v76, v64, v65
    v_cvt_pk_bf16_f32 v77, v66, v67
    v_cvt_pk_bf16_f32 v80, v68, v68
    v_and_b32 v80, 0xffff, v80
    v_and_b32 v81, 0x7fffffff, v69
    v_and_b32 v69, 0x80000000, v69
    v_sub_u32 v81, v81, v80
    v_add_u32 v81, s30, v81
    v_max_i32 v81, 0, v81
    v_and_b32 v81, 0xffff0000, v81
    v_or3_b32 v78, v81, v80, v69
    v_cvt_pk_bf16_f32 v80, v70, v70
    v_and_b32 v80, 0xffff, v80
    v_and_b32 v81, 0x7fffffff, v71
    v_and_b32 v71, 0x80000000, v71
    v_sub_u32 v81, v81, v80
    v_add_u32 v81, s30, v81
    v_max_i32 v81, 0, v81
    v_and_b32 v81, 0xffff0000, v81
    v_or3_b32 v79, v81, v80, v71
    s_barrier
    s_mov_b64 exec, s[34:35]
    global_store_dwordx4 v55, v[72:75], s[26:27] offset:0 sc1
    global_store_dwordx4 v55, v[76:79], s[26:27] offset:64 sc1
    s_mov_b64 exec, -1
    s_cmp_lg_u32 s2, 249
    s_cbranch_scc1 L_TAU
    s_cmp_lg_u32 s36, 5
    s_cbranch_scc1 L_TAU
    v_mov_b32 v80, 0x71807180
    v_mov_b32 v81, v80
    v_mov_b32 v82, 0
    v_mov_b32 v83, 0
    v_lshlrev_b32 v7, 4, v127
    v_add_u32 v7, 2564096, v7
    s_mov_b64 exec, 0xffff
    global_store_dwordx4 v7, v[80:83], s[26:27] sc1
    s_mov_b64 exec, -1
L_TAU:
    s_waitcnt lgkmcnt(0)
    v_mfma_f32_16x16x32_bf16 v[56:59], v[16:19], v[8:11], 0
    v_mfma_f32_16x16x32_bf16 v[56:59], v[20:23], v[12:15], v[56:59]
    v_mfma_f32_16x16x32_bf16 v[60:63], v[24:27], v[8:11], 0
    v_mfma_f32_16x16x32_bf16 v[60:63], v[28:31], v[12:15], v[60:63]
    v_mfma_f32_16x16x32_bf16 v[64:67], v[32:35], v[8:11], 0
    v_mfma_f32_16x16x32_bf16 v[64:67], v[36:39], v[12:15], v[64:67]
    v_mfma_f32_16x16x32_bf16 v[68:71], v[40:43], v[8:11], 0
    v_mfma_f32_16x16x32_bf16 v[68:71], v[44:47], v[12:15], v[68:71]
    s_mov_b32 s34, 0xc2700000
    s_nop 6
    ds_write_b128 v53, v[60:63] offset:0
    v_mul_f32 v56, s32, v56
    v_med3_f32 v56, v56, v54, s33
    v_add_f32 v16, s34, v56
    v_mul_f32 v58, s32, v58
    v_med3_f32 v58, v58, v54, s33
    v_add_f32 v17, s34, v58
    v_mul_f32 v57, s32, v57
    v_med3_f32 v57, v57, v54, s33
    v_add_f32 v18, s34, v57
    v_mul_f32 v59, s32, v59
    v_med3_f32 v59, v59, v54, s33
    v_add_f32 v19, s34, v59
    ds_write_b128 v51, v[16:19] offset:0
    ds_write_b128 v53, v[68:71] offset:64
    v_mul_f32 v64, s32, v64
    v_med3_f32 v64, v64, v54, s33
    v_add_f32 v16, s34, v64
    v_mul_f32 v66, s32, v66
    v_med3_f32 v66, v66, v54, s33
    v_add_f32 v17, s34, v66
    v_mul_f32 v65, s32, v65
    v_med3_f32 v65, v65, v54, s33
    v_add_f32 v18, s34, v65
    v_mul_f32 v67, s32, v67
    v_med3_f32 v67, v67, v54, s33
    v_add_f32 v19, s34, v67
    ds_write_b128 v51, v[16:19] offset:64
    v_mov_b32 v16, 29444
    v_mov_b32 v17, 1
    s_waitcnt vmcnt(0)
    s_mov_b64 exec, 1
    ds_add_rtn_u32 v18, v16, v17
    s_waitcnt lgkmcnt(0)
    v_readfirstlane_b32 s30, v18
    s_mov_b64 exec, -1
    s_cmp_lg_u32 s30, 5
    s_cbranch_scc1 L_PHASEB
    s_lshl_b32 s30, s2, 4
    s_add_u32 s30, s30, 2572288
    v_mov_b32 v16, s30
    v_mov_b32 v18, s28
    v_mov_b32 v19, s29
    s_mov_b64 exec, 1
    global_store_dwordx2 v16, v[18:19], s[26:27] sc1
    s_mov_b64 exec, -1
L_PHASEB:
    v_lshlrev_b32 v2, 3, v127
    ds_read_b64 v[118:119], v2 offset:29504
    s_mov_b32 s33, 0
    s_mov_b32 s38, s29
    s_mov_b32 s39, s28
    s_not_b64 s[80:81], s[64:65]
    s_not_b64 s[82:83], s[64:65]
    s_not_b64 s[84:85], s[66:67]
    s_not_b64 s[86:87], s[66:67]
L_POLL:
    s_mov_b64 exec, s[80:81]
    s_cbranch_execz L_NP0
    global_load_dwordx4 v[8:11], v96, s[26:27] offset:0 sc1
L_NP0:
    s_mov_b64 exec, s[82:83]
    s_cbranch_execz L_NP1
    global_load_dwordx4 v[12:15], v96, s[26:27] offset:128 sc1
L_NP1:
    s_mov_b64 exec, s[84:85]
    s_cbranch_execz L_NP2
    global_load_dwordx4 v[16:19], v96, s[26:27] offset:256 sc1
L_NP2:
    s_mov_b64 exec, s[86:87]
    s_cbranch_execz L_NP3
    global_load_dwordx4 v[20:23], v96, s[26:27] offset:384 sc1
L_NP3:
    s_waitcnt vmcnt(0)
    s_mov_b64 exec, s[80:81]
    v_cmp_eq_u32 vcc, s28, v9
    v_cmp_eq_u64 s[34:35], v[10:11], s[38:39]
    s_nop 0
    s_and_b64 s[34:35], s[34:35], vcc
    s_andn2_b64 s[80:81], s[80:81], s[34:35]
    s_mov_b64 exec, s[82:83]
    v_cmp_eq_u32 vcc, s28, v13
    v_cmp_eq_u64 s[34:35], v[14:15], s[38:39]
    s_nop 0
    s_and_b64 s[34:35], s[34:35], vcc
    s_andn2_b64 s[82:83], s[82:83], s[34:35]
    s_mov_b64 exec, s[84:85]
    v_cmp_eq_u32 vcc, s28, v17
    v_cmp_eq_u64 s[34:35], v[18:19], s[38:39]
    s_nop 0
    s_and_b64 s[34:35], s[34:35], vcc
    s_andn2_b64 s[84:85], s[84:85], s[34:35]
    s_mov_b64 exec, s[86:87]
    v_cmp_eq_u32 vcc, s28, v21
    v_cmp_eq_u64 s[34:35], v[22:23], s[38:39]
    s_nop 0
    s_and_b64 s[34:35], s[34:35], vcc
    s_andn2_b64 s[86:87], s[86:87], s[34:35]
    s_mov_b64 exec, -1
    s_or_b64 s[34:35], s[80:81], s[82:83]
    s_or_b64 s[36:37], s[84:85], s[86:87]
    s_or_b64 s[34:35], s[34:35], s[36:37]
    s_cbranch_scc0 L_READY
    s_add_u32 s33, s33, 1
    s_cmp_ge_u32 s33, 1048576
    s_cbranch_scc1 L_END
    s_sleep 2
    s_branch L_POLL
L_READY:
L_ROUND:
    v_add_u32 v2, s68, v125
    v_add_u32 v3, 16, v2
    s_lshl_b32 s30, s3, 4
    v_lshl_add_u32 v4, v126, 2, s30
    v_mul_u32_u24 v4, 30848, v4
    v_mad_u32_u24 v4, v2, 12, v4
    v_lshrrev_b32 v9, 20, v8
    v_and_b32 v8, 0xfffff, v8
    v_cmp_gt_u32 s[48:49], v9, v2
    v_cmp_gt_u32 s[56:57], v9, v3
    v_mad_u32_u24 v10, v8, 12, v4
    v_lshrrev_b32 v13, 20, v12
    v_and_b32 v12, 0xfffff, v12
    v_cmp_gt_u32 s[50:51], v13, v2
    v_cmp_gt_u32 s[58:59], v13, v3
    v_mad_u32_u24 v14, v12, 12, v4
    v_lshrrev_b32 v17, 20, v16
    v_and_b32 v16, 0xfffff, v16
    v_cmp_gt_u32 s[52:53], v17, v2
    v_cmp_gt_u32 s[60:61], v17, v3
    v_mad_u32_u24 v18, v16, 12, v4
    v_lshrrev_b32 v21, 20, v20
    v_and_b32 v20, 0xfffff, v20
    v_cmp_gt_u32 s[54:55], v21, v2
    v_cmp_gt_u32 s[62:63], v21, v3
    v_mad_u32_u24 v22, v20, 12, v4
    s_add_u32 s30, s68, 32
    s_andn2_b64 s[48:49], s[48:49], s[64:65]
    s_andn2_b64 s[56:57], s[56:57], s[64:65]
    s_cbranch_scc0 L_NMORE0
    s_mov_b64 exec, s[56:57]
    v_cmp_lt_u32 vcc, s30, v9
    s_mov_b64 exec, -1
    s_cmp_eq_u64 vcc, 0
    s_cbranch_scc1 L_NMORE0
    v_mov_b32 v5, 29440
    v_mov_b32 v6, 1
    ds_write_b32 v5, v6
L_NMORE0:
    s_andn2_b64 s[50:51], s[50:51], s[64:65]
    s_andn2_b64 s[58:59], s[58:59], s[64:65]
    s_cbranch_scc0 L_NMORE1
    s_mov_b64 exec, s[58:59]
    v_cmp_lt_u32 vcc, s30, v13
    s_mov_b64 exec, -1
    s_cmp_eq_u64 vcc, 0
    s_cbranch_scc1 L_NMORE1
    v_mov_b32 v5, 29440
    v_mov_b32 v6, 1
    ds_write_b32 v5, v6
L_NMORE1:
    s_andn2_b64 s[52:53], s[52:53], s[66:67]
    s_andn2_b64 s[60:61], s[60:61], s[66:67]
    s_cbranch_scc0 L_NMORE2
    s_mov_b64 exec, s[60:61]
    v_cmp_lt_u32 vcc, s30, v17
    s_mov_b64 exec, -1
    s_cmp_eq_u64 vcc, 0
    s_cbranch_scc1 L_NMORE2
    v_mov_b32 v5, 29440
    v_mov_b32 v6, 1
    ds_write_b32 v5, v6
L_NMORE2:
    s_andn2_b64 s[54:55], s[54:55], s[66:67]
    s_andn2_b64 s[62:63], s[62:63], s[66:67]
    s_cbranch_scc0 L_NMORE3
    s_mov_b64 exec, s[62:63]
    v_cmp_lt_u32 vcc, s30, v21
    s_mov_b64 exec, -1
    s_cmp_eq_u64 vcc, 0
    s_cbranch_scc1 L_NMORE3
    v_mov_b32 v5, 29440
    v_mov_b32 v6, 1
    ds_write_b32 v5, v6
L_NMORE3:
    s_mov_b64 exec, s[48:49]
    s_mov_b32 s31, 0
    buffer_load_dwordx3 v[24:26], v10, s[40:43], s31 offen sc1
    s_mov_b64 exec, s[50:51]
    s_mov_b32 s31, 30848
    buffer_load_dwordx3 v[28:30], v14, s[40:43], s31 offen sc1
    s_mov_b64 exec, s[52:53]
    s_mov_b32 s31, 61696
    buffer_load_dwordx3 v[32:34], v18, s[40:43], s31 offen sc1
    s_mov_b64 exec, s[54:55]
    s_mov_b32 s31, 92544
    buffer_load_dwordx3 v[36:38], v22, s[40:43], s31 offen sc1
    s_cmp_eq_u64 s[56:57], 0
    s_cbranch_scc1 L_NL10
    s_mov_b64 exec, s[56:57]
    s_mov_b32 s31, 0
    buffer_load_dwordx3 v[40:42], v10, s[40:43], s31 offen offset:192 sc1
L_NL10:
    s_cmp_eq_u64 s[58:59], 0
    s_cbranch_scc1 L_NL11
    s_mov_b64 exec, s[58:59]
    s_mov_b32 s31, 30848
    buffer_load_dwordx3 v[44:46], v14, s[40:43], s31 offen offset:192 sc1
L_NL11:
    s_cmp_eq_u64 s[60:61], 0
    s_cbranch_scc1 L_NL12
    s_mov_b64 exec, s[60:61]
    s_mov_b32 s31, 61696
    buffer_load_dwordx3 v[48:50], v18, s[40:43], s31 offen offset:192 sc1
L_NL12:
    s_cmp_eq_u64 s[62:63], 0
    s_cbranch_scc1 L_NL13
    s_mov_b64 exec, s[62:63]
    s_mov_b32 s31, 92544
    buffer_load_dwordx3 v[52:54], v22, s[40:43], s31 offen offset:192 sc1
L_NL13:
    s_mov_b64 exec, -1
    s_waitcnt vmcnt(0)
    global_load_dwordx2 v[22:23], v97, s[26:27] sc1
    s_mov_b64 exec, s[48:49]
    v_and_b32 v64, 0xff, v26
    ds_add_rtn_u32 v56, v64, v98 offset:28672
    s_mov_b64 exec, s[50:51]
    v_and_b32 v65, 0xff, v30
    ds_add_rtn_u32 v57, v65, v98 offset:28672
    s_mov_b64 exec, s[52:53]
    v_and_b32 v66, 0xff, v34
    ds_add_rtn_u32 v58, v66, v98 offset:28672
    s_mov_b64 exec, s[54:55]
    v_and_b32 v67, 0xff, v38
    ds_add_rtn_u32 v59, v67, v98 offset:28672
    s_cmp_eq_u64 s[56:57], 0
    s_cbranch_scc1 L_NB1R0
    s_mov_b64 exec, s[56:57]
    v_and_b32 v68, 0xff, v42
    ds_add_rtn_u32 v60, v68, v98 offset:28672
L_NB1R0:
    s_cmp_eq_u64 s[58:59], 0
    s_cbranch_scc1 L_NB1R1
    s_mov_b64 exec, s[58:59]
    v_and_b32 v69, 0xff, v46
    ds_add_rtn_u32 v61, v69, v98 offset:28672
L_NB1R1:
    s_cmp_eq_u64 s[60:61], 0
    s_cbranch_scc1 L_NB1R2
    s_mov_b64 exec, s[60:61]
    v_and_b32 v70, 0xff, v50
    ds_add_rtn_u32 v62, v70, v98 offset:28672
L_NB1R2:
    s_cmp_eq_u64 s[62:63], 0
    s_cbranch_scc1 L_NB1R3
    s_mov_b64 exec, s[62:63]
    v_and_b32 v71, 0xff, v54
    ds_add_rtn_u32 v63, v71, v98 offset:28672
L_NB1R3:
    s_mov_b64 exec, -1
    v_mov_b32 v6, 29440
    v_cmp_gt_u32 vcc, 40, v127
    s_waitcnt lgkmcnt(0)
    s_barrier
    ds_read_b32 v5, v99 offset:28672
    ds_read_b32 v6, v6
    s_waitcnt lgkmcnt(0)
    v_add_u32 v4, 7, v5
    v_lshrrev_b32 v4, 3, v4
    v_max_u32 v4, 1, v4
    v_cndmask_b32 v4, 0, v4, vcc
    v_readfirstlane_b32 s69, v6
    v_mov_b32 v116, v4
    s_nop 1
    v_add_u32_dpp v116, v116, v116 row_shr:1 row_mask:0xf bank_mask:0xf bound_ctrl:0
    s_nop 1
    v_add_u32_dpp v116, v116, v116 row_shr:2 row_mask:0xf bank_mask:0xf bound_ctrl:0
    s_nop 1
    v_add_u32_dpp v116, v116, v116 row_shr:4 row_mask:0xf bank_mask:0xf bound_ctrl:0
    s_nop 1
    v_add_u32_dpp v116, v116, v116 row_shr:8 row_mask:0xf bank_mask:0xf bound_ctrl:0
    s_nop 1
    v_add_u32_dpp v116, v116, v116 row_bcast:15 row_mask:0xa bank_mask:0xf
    s_nop 1
    v_add_u32_dpp v116, v116, v116 row_bcast:31 row_mask:0xc bank_mask:0xf
    s_nop 1
    v_sub_u32 v117, v116, v4
    v_readlane_b32 s70, v116, 63
    v_lshlrev_b32 v3, 3, v117
    s_mov_b32 s30, 56192
    s_mov_b32 s31, 89728
    ds_bpermute_b32 v8, v64, v3
    ds_bpermute_b32 v9, v65, v3
    ds_bpermute_b32 v10, v66, v3
    ds_bpermute_b32 v11, v67, v3
    s_cmp_eq_u64 s[56:57], 0
    s_cbranch_scc1 L_NB1P0
    ds_bpermute_b32 v12, v68, v3
L_NB1P0:
    s_cmp_eq_u64 s[58:59], 0
    s_cbranch_scc1 L_NB1P1
    ds_bpermute_b32 v13, v69, v3
L_NB1P1:
    s_cmp_eq_u64 s[60:61], 0
    s_cbranch_scc1 L_NB1P2
    ds_bpermute_b32 v14, v70, v3
L_NB1P2:
    s_cmp_eq_u64 s[62:63], 0
    s_cbranch_scc1 L_NB1P3
    ds_bpermute_b32 v15, v71, v3
L_NB1P3:
    s_cmp_ge_u32 s3, 5
    s_cbranch_scc1 L_NOPLK
    s_lshl_b32 s32, s3, 3
    v_lshrrev_b32 v16, 3, v127
    v_add_u32 v16, s32, v16
    v_lshlrev_b32 v16, 2, v16
    v_add_u32 v17, v3, v5
    v_lshlrev_b32 v18, 3, v116
    ds_bpermute_b32 v17, v16, v17
    ds_bpermute_b32 v18, v16, v18
L_NOPLK:
    s_mul_i32 s71, s70, s3
    s_lshr_b32 s71, s71, 4
    s_add_u32 s32, s3, 1
    s_mul_i32 s72, s70, s32
    s_lshr_b32 s72, s72, 4
    v_cmp_ge_u32 vcc, s71, v116
    s_waitcnt lgkmcnt(0)
    s_bcnt1_i32_b64 s73, vcc
    s_mov_b64 exec, s[48:49]
    v_add_u32 v8, v8, v56
    v_lshrrev_b32 v26, 8, v26
    v_lshl_add_u32 v19, v8, 2, s30
    v_lshl_add_u32 v21, v8, 3, s31
    ds_write_b32 v19, v26
    ds_write_b64 v21, v[24:25]
    s_mov_b64 exec, s[50:51]
    v_add_u32 v9, v9, v57
    v_lshrrev_b32 v30, 8, v30
    v_lshl_add_u32 v19, v9, 2, s30
    v_lshl_add_u32 v21, v9, 3, s31
    ds_write_b32 v19, v30
    ds_write_b64 v21, v[28:29]
    s_mov_b64 exec, s[52:53]
    v_add_u32 v10, v10, v58
    v_lshrrev_b32 v34, 8, v34
    v_lshl_add_u32 v19, v10, 2, s30
    v_lshl_add_u32 v21, v10, 3, s31
    ds_write_b32 v19, v34
    ds_write_b64 v21, v[32:33]
    s_mov_b64 exec, s[54:55]
    v_add_u32 v11, v11, v59
    v_lshrrev_b32 v38, 8, v38
    v_lshl_add_u32 v19, v11, 2, s30
    v_lshl_add_u32 v21, v11, 3, s31
    ds_write_b32 v19, v38
    ds_write_b64 v21, v[36:37]
    s_cmp_eq_u64 s[56:57], 0
    s_cbranch_scc1 L_NB1S0
    s_mov_b64 exec, s[56:57]
    v_add_u32 v12, v12, v60
    v_lshrrev_b32 v42, 8, v42
    v_lshl_add_u32 v19, v12, 2, s30
    v_lshl_add_u32 v21, v12, 3, s31
    ds_write_b32 v19, v42
    ds_write_b64 v21, v[40:41]
L_NB1S0:
    s_cmp_eq_u64 s[58:59], 0
    s_cbranch_scc1 L_NB1S1
    s_mov_b64 exec, s[58:59]
    v_add_u32 v13, v13, v61
    v_lshrrev_b32 v46, 8, v46
    v_lshl_add_u32 v19, v13, 2, s30
    v_lshl_add_u32 v21, v13, 3, s31
    ds_write_b32 v19, v46
    ds_write_b64 v21, v[44:45]
L_NB1S1:
    s_cmp_eq_u64 s[60:61], 0
    s_cbranch_scc1 L_NB1S2
    s_mov_b64 exec, s[60:61]
    v_add_u32 v14, v14, v62
    v_lshrrev_b32 v50, 8, v50
    v_lshl_add_u32 v19, v14, 2, s30
    v_lshl_add_u32 v21, v14, 3, s31
    ds_write_b32 v19, v50
    ds_write_b64 v21, v[48:49]
L_NB1S2:
    s_cmp_eq_u64 s[62:63], 0
    s_cbranch_scc1 L_NB1S3
    s_mov_b64 exec, s[62:63]
    v_add_u32 v15, v15, v63
    v_lshrrev_b32 v54, 8, v54
    v_lshl_add_u32 v19, v15, 2, s30
    v_lshl_add_u32 v21, v15, 3, s31
    ds_write_b32 v19, v54
    ds_write_b64 v21, v[52:53]
L_NB1S3:
    s_mov_b64 exec, -1
    v_mov_b32 v11, 10000
    v_mov_b32 v12, 0
    v_mov_b32 v13, 0
    s_cmp_gt_u32 s3, 5
    s_cbranch_scc1 L_NOPAD
    v_and_b32 v16, 7, v127
    v_add_u32 v16, v17, v16
    v_cmp_lt_u32 vcc, v16, v18
    s_cmp_lt_u32 s3, 5
    s_cbranch_scc1 L_PADW
    s_lshl_b32 s32, s70, 3
    v_add_u32 v16, s32, v127
    s_mov_b64 vcc, -1
L_PADW:
    v_lshl_add_u32 v14, v16, 2, s30
    v_lshl_add_u32 v15, v16, 3, s31
    s_mov_b64 exec, vcc
    ds_write_b32 v14, v11
    ds_write_b64 v15, v[12:13]
    s_mov_b64 exec, -1
L_NOPAD:
    v_readlane_b32 s74, v116, s73
    s_lshl_b32 s32, s71, 5
    v_add_u32 v2, s32, v122
    s_lshl_b32 s32, s71, 1
    v_mad_u32_u24 v3, v121, s32, v120
    s_mul_i32 s32, s73, 272
    v_add_u32 v89, s32, v91
    s_add_u32 s32, s73, s3
    s_lshl_b32 s32, s32, 9
    v_add_u32 v88, s32, v123
    s_min_u32 s74, s74, s72
    s_sub_u32 s75, s74, s71
    s_sub_u32 s75, s75, 1
    s_mov_b32 s33, 0
    s_cmp_eq_u32 s3, 15
    s_cselect_b32 s34, 0xfc00fc00, 0
    s_mov_b32 s35, s34
L_GPOLL:
    s_waitcnt vmcnt(0)
    v_cmp_eq_u64 s[36:37], v[22:23], s[28:29]
    s_nop 0
    s_or_b64 s[36:37], s[36:37], s[34:35]
    s_cmp_eq_u64 s[36:37], -1
    s_cbranch_scc1 L_GOK
    s_add_u32 s33, s33, 1
    s_cmp_ge_u32 s33, 1048576
    s_cbranch_scc1 L_END
    s_sleep 2
    global_load_dwordx2 v[22:23], v97, s[26:27] sc1
    s_branch L_GPOLL
L_GOK:
    s_waitcnt lgkmcnt(0)
    s_barrier
    ds_read_b32 v92, v2 offset:0
    ds_read_b32 v94, v2 offset:16
    ds_read_b32 v56, v2 offset:32
    ds_read_b32 v58, v2 offset:48
    ds_read_b32 v60, v2 offset:64
    ds_read_b32 v62, v2 offset:80
    ds_read_b128 v[96:99], v89
    ds_read_b128 v[108:111], v89 offset:272
    ds_read_b64 v[100:101], v3
    ds_read_b64 v[104:105], v3 offset:32
    v_mov_b32 v57, v93
    v_mov_b32 v59, v93
    v_mov_b32 v61, v93
    v_mov_b32 v63, v93
    v_pk_mov_b32 v[8:9], v[118:119], v[118:119] op_sel:[0,1]
    v_pk_mov_b32 v[14:15], v[118:119], v[118:119] op_sel:[0,1]
    v_pk_mov_b32 v[20:21], v[118:119], v[118:119] op_sel:[0,1]
    v_pk_mov_b32 v[26:27], v[118:119], v[118:119] op_sel:[0,1]
    v_pk_mov_b32 v[32:33], v[118:119], v[118:119] op_sel:[0,1]
    v_pk_mov_b32 v[38:39], v[118:119], v[118:119] op_sel:[0,1]
    v_pk_mov_b32 v[44:45], v[118:119], v[118:119] op_sel:[0,1]
    v_pk_mov_b32 v[50:51], v[118:119], v[118:119] op_sel:[0,1]
    v_pk_mov_b32 v[68:69], 0, 0
    v_pk_mov_b32 v[70:71], 0, 0
    v_pk_mov_b32 v[72:73], 0, 0
    v_pk_mov_b32 v[74:75], 0, 0
    s_waitcnt lgkmcnt(9)
    buffer_load_dwordx4 v[10:13], v[92:93], s[44:47], 0 idxen offen
    s_waitcnt lgkmcnt(8)
    buffer_load_dwordx4 v[16:19], v[94:95], s[44:47], 0 idxen offen
    s_waitcnt lgkmcnt(7)
    buffer_load_dwordx4 v[22:25], v[56:57], s[44:47], 0 idxen offen
    s_waitcnt lgkmcnt(6)
    buffer_load_dwordx4 v[28:31], v[58:59], s[44:47], 0 idxen offen
    s_waitcnt lgkmcnt(5)
    buffer_load_dwordx4 v[34:37], v[60:61], s[44:47], 0 idxen offen
    s_waitcnt lgkmcnt(4)
    buffer_load_dwordx4 v[40:43], v[62:63], s[44:47], 0 idxen offen
    s_cmp_ge_u32 s3, 5
    s_cbranch_scc1 L_NOSEG
    v_cvt_f32_u32 v76, s70
    v_rcp_f32 v76, v76
    v_lshlrev_b32 v77, 4, v117
    v_add_u32 v77, 16, v77
    v_cvt_f32_u32 v77, v77
    v_lshlrev_b32 v78, 4, v116
    v_cvt_f32_u32 v78, v78
    v_add_f32 v77, -0.5, v77
    v_add_f32 v78, -0.5, v78
    v_mul_f32 v77, v77, v76
    v_mul_f32 v78, v78, v76
    v_cvt_u32_f32 v77, v77
    v_cvt_u32_f32 v78, v78
    v_lshrrev_b32 v4, 3, v0
    v_sub_u32 v78, v78, v77
    v_add_u32 v78, 1, v78
    v_add_u32 v77, v77, v127
    v_lshl_or_b32 v77, v78, 16, v77
    v_lshlrev_b32 v5, 2, v4
    ds_bpermute_b32 v5, v5, v77
    v_and_b32 v6, 7, v0
    v_lshlrev_b32 v6, 4, v6
    v_mul_u32_u24 v4, 272, v4
    v_lshl_add_u32 v4, v6, 1, v4
    v_add_u32 v4, 43136, v4
    s_waitcnt lgkmcnt(0)
    v_lshrrev_b32 v7, 16, v5
    v_and_b32 v5, 0xffff, v5
    v_lshl_add_u32 v5, v5, 9, v6
L_NOSEG:
    s_setprio 3
    s_sub_u32 s76, s72, s71
    s_waitcnt lgkmcnt(0)
L_LOOP:
    s_waitcnt vmcnt(5)
    v_mfma_f32_16x16x32_bf16 v[56:59], v[100:103], v[8:11], v[96:99]
    ds_read_b32 v92, v2 offset:96
    ds_read_b32 v94, v2 offset:112
    v_lshlrev_b32 v64, 16, v12
    v_lshlrev_b32 v65, 16, v13
    s_waitcnt vmcnt(4)
    v_mfma_f32_16x16x32_bf16 v[60:63], v[104:107], v[14:17], v[96:99]
    v_lshlrev_b32 v66, 16, v18
    v_lshlrev_b32 v67, 16, v19
    s_sub_u32 s75, s75, 1
    ds_read_b64 v[100:101], v3 offset:64
    ds_read_b64 v[104:105], v3 offset:96
    v_exp_f32 v56, v56 clamp
    v_exp_f32 v57, v57 clamp
    v_exp_f32 v58, v58 clamp
    v_exp_f32 v59, v59 clamp
    s_waitcnt lgkmcnt(2)
    buffer_load_dwordx4 v[46:49], v[92:93], s[44:47], 0 idxen offen
    buffer_load_dwordx4 v[52:55], v[94:95], s[44:47], 0 idxen offen
    v_exp_f32 v60, v60 clamp
    v_exp_f32 v61, v61 clamp
    v_exp_f32 v62, v62 clamp
    v_exp_f32 v63, v63 clamp
    v_pk_add_f32 v[56:57], v[56:57], s[78:79]
    v_pk_add_f32 v[58:59], v[58:59], s[78:79]
    v_pk_add_f32 v[60:61], v[60:61], s[78:79]
    v_pk_add_f32 v[62:63], v[62:63], s[78:79]
    v_pk_mul_f32 v[76:77], v[56:57], v[60:61]
    v_pk_mul_f32 v[78:79], v[58:59], v[62:63]
    v_pk_mul_f32 v[80:81], v[64:65], v[60:61]
    v_rcp_f32 v76, v76
    v_rcp_f32 v77, v77
    v_pk_mul_f32 v[82:83], v[12:13], v[62:63]
    v_rcp_f32 v78, v78
    v_rcp_f32 v79, v79
    v_pk_fma_f32 v[80:81], v[66:67], v[56:57], v[80:81]
    v_pk_fma_f32 v[82:83], v[18:19], v[58:59], v[82:83]
    v_pk_add_f32 v[84:85], v[56:57], v[60:61]
    v_pk_add_f32 v[86:87], v[58:59], v[62:63]
    v_pk_fma_f32 v[68:69], v[76:77], v[80:81], v[68:69]
    v_pk_fma_f32 v[70:71], v[78:79], v[82:83], v[70:71]
    v_pk_fma_f32 v[72:73], v[76:77], v[84:85], v[72:73]
    v_pk_fma_f32 v[74:75], v[78:79], v[86:87], v[74:75]
    s_waitcnt lgkmcnt(0)
    s_cbranch_scc1 L_SB0
L_RB0:
    s_waitcnt vmcnt(5)
    v_mfma_f32_16x16x32_bf16 v[56:59], v[100:103], v[20:23], v[96:99]
    ds_read_b32 v92, v2 offset:128
    ds_read_b32 v94, v2 offset:144
    v_lshlrev_b32 v64, 16, v24
    v_lshlrev_b32 v65, 16, v25
    s_waitcnt vmcnt(4)
    v_mfma_f32_16x16x32_bf16 v[60:63], v[104:107], v[26:29], v[96:99]
    v_lshlrev_b32 v66, 16, v30
    v_lshlrev_b32 v67, 16, v31
    s_sub_u32 s75, s75, 1
    ds_read_b64 v[100:101], v3 offset:128
    ds_read_b64 v[104:105], v3 offset:160
    v_exp_f32 v56, v56 clamp
    v_exp_f32 v57, v57 clamp
    v_exp_f32 v58, v58 clamp
    v_exp_f32 v59, v59 clamp
    s_waitcnt lgkmcnt(2)
    buffer_load_dwordx4 v[10:13], v[92:93], s[44:47], 0 idxen offen
    buffer_load_dwordx4 v[16:19], v[94:95], s[44:47], 0 idxen offen
    v_exp_f32 v60, v60 clamp
    v_exp_f32 v61, v61 clamp
    v_exp_f32 v62, v62 clamp
    v_exp_f32 v63, v63 clamp
    v_pk_add_f32 v[56:57], v[56:57], s[78:79]
    v_pk_add_f32 v[58:59], v[58:59], s[78:79]
    v_pk_add_f32 v[60:61], v[60:61], s[78:79]
    v_pk_add_f32 v[62:63], v[62:63], s[78:79]
    v_pk_mul_f32 v[76:77], v[56:57], v[60:61]
    v_pk_mul_f32 v[78:79], v[58:59], v[62:63]
    v_pk_mul_f32 v[80:81], v[64:65], v[60:61]
    v_rcp_f32 v76, v76
    v_rcp_f32 v77, v77
    v_pk_mul_f32 v[82:83], v[24:25], v[62:63]
    v_rcp_f32 v78, v78
    v_rcp_f32 v79, v79
    v_pk_fma_f32 v[80:81], v[66:67], v[56:57], v[80:81]
    v_pk_fma_f32 v[82:83], v[30:31], v[58:59], v[82:83]
    v_pk_add_f32 v[84:85], v[56:57], v[60:61]
    v_pk_add_f32 v[86:87], v[58:59], v[62:63]
    v_pk_fma_f32 v[68:69], v[76:77], v[80:81], v[68:69]
    v_pk_fma_f32 v[70:71], v[78:79], v[82:83], v[70:71]
    v_pk_fma_f32 v[72:73], v[76:77], v[84:85], v[72:73]
    v_pk_fma_f32 v[74:75], v[78:79], v[86:87], v[74:75]
    s_waitcnt lgkmcnt(0)
    s_cbranch_scc1 L_SB2
L_RB2:
    s_waitcnt vmcnt(5)
    v_mfma_f32_16x16x32_bf16 v[56:59], v[100:103], v[32:35], v[96:99]
    ds_read_b32 v92, v2 offset:160
    ds_read_b32 v94, v2 offset:176
    v_lshlrev_b32 v64, 16, v36
    v_lshlrev_b32 v65, 16, v37
    s_waitcnt vmcnt(4)
    v_mfma_f32_16x16x32_bf16 v[60:63], v[104:107], v[38:41], v[96:99]
    v_lshlrev_b32 v66, 16, v42
    v_lshlrev_b32 v67, 16, v43
    s_sub_u32 s75, s75, 1
    ds_read_b64 v[100:101], v3 offset:192
    ds_read_b64 v[104:105], v3 offset:224
    v_exp_f32 v56, v56 clamp
    v_exp_f32 v57, v57 clamp
    v_exp_f32 v58, v58 clamp
    v_exp_f32 v59, v59 clamp
    s_waitcnt lgkmcnt(2)
    buffer_load_dwordx4 v[22:25], v[92:93], s[44:47], 0 idxen offen
    buffer_load_dwordx4 v[28:31], v[94:95], s[44:47], 0 idxen offen
    v_exp_f32 v60, v60 clamp
    v_exp_f32 v61, v61 clamp
    v_exp_f32 v62, v62 clamp
    v_exp_f32 v63, v63 clamp
    v_pk_add_f32 v[56:57], v[56:57], s[78:79]
    v_pk_add_f32 v[58:59], v[58:59], s[78:79]
    v_pk_add_f32 v[60:61], v[60:61], s[78:79]
    v_pk_add_f32 v[62:63], v[62:63], s[78:79]
    v_pk_mul_f32 v[76:77], v[56:57], v[60:61]
    v_pk_mul_f32 v[78:79], v[58:59], v[62:63]
    v_pk_mul_f32 v[80:81], v[64:65], v[60:61]
    v_rcp_f32 v76, v76
    v_rcp_f32 v77, v77
    v_pk_mul_f32 v[82:83], v[36:37], v[62:63]
    v_rcp_f32 v78, v78
    v_rcp_f32 v79, v79
    v_pk_fma_f32 v[80:81], v[66:67], v[56:57], v[80:81]
    v_pk_fma_f32 v[82:83], v[42:43], v[58:59], v[82:83]
    v_pk_add_f32 v[84:85], v[56:57], v[60:61]
    v_pk_add_f32 v[86:87], v[58:59], v[62:63]
    v_pk_fma_f32 v[68:69], v[76:77], v[80:81], v[68:69]
    v_pk_fma_f32 v[70:71], v[78:79], v[82:83], v[70:71]
    v_pk_fma_f32 v[72:73], v[76:77], v[84:85], v[72:73]
    v_pk_fma_f32 v[74:75], v[78:79], v[86:87], v[74:75]
    s_waitcnt lgkmcnt(0)
    s_cbranch_scc1 L_SB4
L_RB4:
    s_waitcnt vmcnt(5)
    v_mfma_f32_16x16x32_bf16 v[56:59], v[100:103], v[44:47], v[96:99]
    ds_read_b32 v92, v2 offset:192
    ds_read_b32 v94, v2 offset:208
    v_lshlrev_b32 v64, 16, v48
    v_lshlrev_b32 v65, 16, v49
    s_waitcnt vmcnt(4)
    v_mfma_f32_16x16x32_bf16 v[60:63], v[104:107], v[50:53], v[96:99]
    v_lshlrev_b32 v66, 16, v54
    v_lshlrev_b32 v67, 16, v55
    s_sub_u32 s75, s75, 1
    ds_read_b64 v[100:101], v3 offset:256
    ds_read_b64 v[104:105], v3 offset:288
    v_exp_f32 v56, v56 clamp
    v_exp_f32 v57, v57 clamp
    v_exp_f32 v58, v58 clamp
    v_exp_f32 v59, v59 clamp
    s_waitcnt lgkmcnt(2)
    buffer_load_dwordx4 v[34:37], v[92:93], s[44:47], 0 idxen offen
    buffer_load_dwordx4 v[40:43], v[94:95], s[44:47], 0 idxen offen
    v_exp_f32 v60, v60 clamp
    v_exp_f32 v61, v61 clamp
    v_exp_f32 v62, v62 clamp
    v_exp_f32 v63, v63 clamp
    v_pk_add_f32 v[56:57], v[56:57], s[78:79]
    v_pk_add_f32 v[58:59], v[58:59], s[78:79]
    v_pk_add_f32 v[60:61], v[60:61], s[78:79]
    v_pk_add_f32 v[62:63], v[62:63], s[78:79]
    v_pk_mul_f32 v[76:77], v[56:57], v[60:61]
    v_pk_mul_f32 v[78:79], v[58:59], v[62:63]
    v_pk_mul_f32 v[80:81], v[64:65], v[60:61]
    v_rcp_f32 v76, v76
    v_rcp_f32 v77, v77
    v_pk_mul_f32 v[82:83], v[48:49], v[62:63]
    v_rcp_f32 v78, v78
    v_rcp_f32 v79, v79
    v_pk_fma_f32 v[80:81], v[66:67], v[56:57], v[80:81]
    v_pk_fma_f32 v[82:83], v[54:55], v[58:59], v[82:83]
    v_pk_add_f32 v[84:85], v[56:57], v[60:61]
    v_pk_add_f32 v[86:87], v[58:59], v[62:63]
    v_pk_fma_f32 v[68:69], v[76:77], v[80:81], v[68:69]
    v_pk_fma_f32 v[70:71], v[78:79], v[82:83], v[70:71]
    v_pk_fma_f32 v[72:73], v[76:77], v[84:85], v[72:73]
    v_pk_fma_f32 v[74:75], v[78:79], v[86:87], v[74:75]
    s_waitcnt lgkmcnt(0)
    s_cbranch_scc1 L_SB6
L_RB6:
    v_add_u32 v2, 128, v2
    v_add_u32 v3, v90, v3
    s_sub_u32 s76, s76, 4
    s_cmp_gt_i32 s76, 16
    s_cbranch_scc1 L_LOOP
    s_setprio 2
    s_cmp_gt_i32 s76, 8
    s_cbranch_scc1 L_LOOP
    s_setprio 1
    s_cmp_gt_i32 s76, 4
    s_cbranch_scc1 L_LOOP
    s_setprio 0
    s_branch L_LOOP
L_SB0:
    v_permlane32_swap_b32 v68, v72
    v_permlane32_swap_b32 v69, v73
    v_permlane32_swap_b32 v70, v74
    v_permlane32_swap_b32 v71, v75
    v_pk_add_f32 v[68:69], v[68:69], v[72:73]
    v_pk_add_f32 v[70:71], v[70:71], v[74:75]
    s_add_u32 s73, s73, 1
    s_add_u32 s36, s73, 1
    v_permlane16_swap_b32 v68, v70
    v_permlane16_swap_b32 v69, v71
    v_readlane_b32 s37, v116, s73
    s_mul_i32 s36, s36, 272
    v_pk_add_f32 v[72:73], v[68:69], v[70:71]
    v_add_u32 v89, s36, v91
    s_cmp_eq_u32 s74, s72
    ds_write_b64 v88, v[72:73]
    s_cbranch_scc1 L_DONE
    v_pk_mov_b32 v[96:97], v[108:109], v[108:109] op_sel:[0,1]
    v_pk_mov_b32 v[98:99], v[110:111], v[110:111] op_sel:[0,1]
    v_add_u32 v88, 512, v88
    s_min_u32 s37, s37, s72
    v_pk_mov_b32 v[68:69], 0, 0
    v_pk_mov_b32 v[70:71], 0, 0
    ds_read_b128 v[108:111], v89
    v_pk_mov_b32 v[72:73], 0, 0
    v_pk_mov_b32 v[74:75], 0, 0
    s_sub_u32 s75, s37, s74
    s_sub_u32 s75, s75, 1
    s_mov_b32 s74, s37
    s_branch L_RB0
L_SB2:
    v_permlane32_swap_b32 v68, v72
    v_permlane32_swap_b32 v69, v73
    v_permlane32_swap_b32 v70, v74
    v_permlane32_swap_b32 v71, v75
    v_pk_add_f32 v[68:69], v[68:69], v[72:73]
    v_pk_add_f32 v[70:71], v[70:71], v[74:75]
    s_add_u32 s73, s73, 1
    s_add_u32 s36, s73, 1
    v_permlane16_swap_b32 v68, v70
    v_permlane16_swap_b32 v69, v71
    v_readlane_b32 s37, v116, s73
    s_mul_i32 s36, s36, 272
    v_pk_add_f32 v[72:73], v[68:69], v[70:71]
    v_add_u32 v89, s36, v91
    s_cmp_eq_u32 s74, s72
    ds_write_b64 v88, v[72:73]
    s_cbranch_scc1 L_DONE
    v_pk_mov_b32 v[96:97], v[108:109], v[108:109] op_sel:[0,1]
    v_pk_mov_b32 v[98:99], v[110:111], v[110:111] op_sel:[0,1]
    v_add_u32 v88, 512, v88
    s_min_u32 s37, s37, s72
    v_pk_mov_b32 v[68:69], 0, 0
    v_pk_mov_b32 v[70:71], 0, 0
    ds_read_b128 v[108:111], v89
    v_pk_mov_b32 v[72:73], 0, 0
    v_pk_mov_b32 v[74:75], 0, 0
    s_sub_u32 s75, s37, s74
    s_sub_u32 s75, s75, 1
    s_mov_b32 s74, s37
    s_branch L_RB2
L_SB4:
    v_permlane32_swap_b32 v68, v72
    v_permlane32_swap_b32 v69, v73
    v_permlane32_swap_b32 v70, v74
    v_permlane32_swap_b32 v71, v75
    v_pk_add_f32 v[68:69], v[68:69], v[72:73]
    v_pk_add_f32 v[70:71], v[70:71], v[74:75]
    s_add_u32 s73, s73, 1
    s_add_u32 s36, s73, 1
    v_permlane16_swap_b32 v68, v70
    v_permlane16_swap_b32 v69, v71
    v_readlane_b32 s37, v116, s73
    s_mul_i32 s36, s36, 272
    v_pk_add_f32 v[72:73], v[68:69], v[70:71]
    v_add_u32 v89, s36, v91
    s_cmp_eq_u32 s74, s72
    ds_write_b64 v88, v[72:73]
    s_cbranch_scc1 L_DONE
    v_pk_mov_b32 v[96:97], v[108:109], v[108:109] op_sel:[0,1]
    v_pk_mov_b32 v[98:99], v[110:111], v[110:111] op_sel:[0,1]
    v_add_u32 v88, 512, v88
    s_min_u32 s37, s37, s72
    v_pk_mov_b32 v[68:69], 0, 0
    v_pk_mov_b32 v[70:71], 0, 0
    ds_read_b128 v[108:111], v89
    v_pk_mov_b32 v[72:73], 0, 0
    v_pk_mov_b32 v[74:75], 0, 0
    s_sub_u32 s75, s37, s74
    s_sub_u32 s75, s75, 1
    s_mov_b32 s74, s37
    s_branch L_RB4
L_SB6:
    v_permlane32_swap_b32 v68, v72
    v_permlane32_swap_b32 v69, v73
    v_permlane32_swap_b32 v70, v74
    v_permlane32_swap_b32 v71, v75
    v_pk_add_f32 v[68:69], v[68:69], v[72:73]
    v_pk_add_f32 v[70:71], v[70:71], v[74:75]
    s_add_u32 s73, s73, 1
    s_add_u32 s36, s73, 1
    v_permlane16_swap_b32 v68, v70
    v_permlane16_swap_b32 v69, v71
    v_readlane_b32 s37, v116, s73
    s_mul_i32 s36, s36, 272
    v_pk_add_f32 v[72:73], v[68:69], v[70:71]
    v_add_u32 v89, s36, v91
    s_cmp_eq_u32 s74, s72
    ds_write_b64 v88, v[72:73]
    s_cbranch_scc1 L_DONE
    v_pk_mov_b32 v[96:97], v[108:109], v[108:109] op_sel:[0,1]
    v_pk_mov_b32 v[98:99], v[110:111], v[110:111] op_sel:[0,1]
    v_add_u32 v88, 512, v88
    s_min_u32 s37, s37, s72
    v_pk_mov_b32 v[68:69], 0, 0
    v_pk_mov_b32 v[70:71], 0, 0
    ds_read_b128 v[108:111], v89
    v_pk_mov_b32 v[72:73], 0, 0
    v_pk_mov_b32 v[74:75], 0, 0
    s_sub_u32 s75, s37, s74
    s_sub_u32 s75, s75, 1
    s_mov_b32 s74, s37
    s_branch L_RB6
L_DONE:
    s_setprio 0
    s_waitcnt vmcnt(0) lgkmcnt(0)
    s_barrier
    s_cmp_ge_u32 s3, 5
    s_cbranch_scc1 L_MERGED
    ds_read_b128 v[24:27], v5 offset:0
    ds_read_b128 v[28:31], v5 offset:128
    ds_read_b128 v[32:35], v5 offset:256
    ds_read_b128 v[36:39], v5 offset:384
    ds_read_b128 v[40:43], v4
    ds_read_b128 v[44:47], v4 offset:16
    v_add_u32 v5, 512, v5
    s_mov_b32 s36, 1
L_MERGE:
    v_cmp_lt_u32 vcc, s36, v7
    s_nop 1
    s_cmp_eq_u64 vcc, 0
    s_cbranch_scc1 L_MERGE_END
    s_mov_b64 exec, vcc
    ds_read_b128 v[8:11], v5 offset:0
    ds_read_b128 v[12:15], v5 offset:128
    ds_read_b128 v[16:19], v5 offset:256
    ds_read_b128 v[20:23], v5 offset:384
    v_add_u32 v5, 512, v5
    s_add_u32 s36, s36, 1
    s_waitcnt lgkmcnt(0)
    v_pk_add_f32 v[24:25], v[24:25], v[8:9]
    v_pk_add_f32 v[26:27], v[26:27], v[10:11]
    v_pk_add_f32 v[28:29], v[28:29], v[12:13]
    v_pk_add_f32 v[30:31], v[30:31], v[14:15]
    v_pk_add_f32 v[32:33], v[32:33], v[16:17]
    v_pk_add_f32 v[34:35], v[34:35], v[18:19]
    v_pk_add_f32 v[36:37], v[36:37], v[20:21]
    v_pk_add_f32 v[38:39], v[38:39], v[22:23]
    s_mov_b64 exec, -1
    s_branch L_MERGE
L_MERGE_END:
    s_waitcnt lgkmcnt(0)
    s_or_b32 s36, s68, s69
    s_cmp_eq_u32 s36, 0
    s_cbranch_scc1 L_MERGED
    s_mul_i32 s36, s2, 20480
    s_add_u32 s36, s36, 14155776
    v_lshl_add_u32 v48, v0, 6, s36
    s_cmp_eq_u32 s68, 0
    s_cbranch_scc1 L_NOPREV
    global_load_dwordx4 v[8:11], v48, s[26:27] offset:0 sc1
    global_load_dwordx4 v[12:15], v48, s[26:27] offset:16 sc1
    global_load_dwordx4 v[16:19], v48, s[26:27] offset:32 sc1
    global_load_dwordx4 v[20:23], v48, s[26:27] offset:48 sc1
    s_waitcnt vmcnt(0)
    v_pk_add_f32 v[24:25], v[24:25], v[8:9]
    v_pk_add_f32 v[26:27], v[26:27], v[10:11]
    v_pk_add_f32 v[28:29], v[28:29], v[12:13]
    v_pk_add_f32 v[30:31], v[30:31], v[14:15]
    v_pk_add_f32 v[32:33], v[32:33], v[16:17]
    v_pk_add_f32 v[34:35], v[34:35], v[18:19]
    v_pk_add_f32 v[36:37], v[36:37], v[20:21]
    v_pk_add_f32 v[38:39], v[38:39], v[22:23]
L_NOPREV:
    s_cmp_eq_u32 s69, 0
    s_cbranch_scc1 L_MERGED
    global_store_dwordx4 v48, v[24:27], s[26:27] offset:0 sc1
    global_store_dwordx4 v48, v[28:31], s[26:27] offset:16 sc1
    global_store_dwordx4 v48, v[32:35], s[26:27] offset:32 sc1
    global_store_dwordx4 v48, v[36:39], s[26:27] offset:48 sc1
    s_waitcnt vmcnt(0)
L_MERGED:
    s_cmp_eq_u32 s69, 0
    s_cbranch_scc1 L_EPI
    s_add_u32 s68, s68, 32
    s_cmp_lg_u32 s3, 0
    s_cbranch_scc1 L_NOCLR
    v_mov_b32 v9, 0
    v_lshlrev_b32 v10, 2, v127
    ds_write_b32 v10, v9 offset:28672
    v_mov_b32 v10, 29440
    ds_write_b32 v10, v9
L_NOCLR:
    s_and_b32 s30, s2, 7
    s_lshl_b32 s30, s30, 5
    s_lshr_b32 s31, s2, 3
    s_or_b32 s31, s30, s31
    s_lshr_b32 s30, s31, 3
    s_mul_i32 s30, s30, 33152
    s_and_b32 s31, s31, 7
    s_lshl_b32 s31, s31, 4
    s_add_u32 s30, s30, s31
    s_lshl_b32 s31, s3, 11
    s_add_u32 s30, s30, s31
    s_add_u32 s30, s30, 2621440
    v_lshl_add_u32 v2, v126, 9, s30
    s_lshl_b32 s30, s3, 8
    s_add_u32 s30, s30, 2572288
    v_lshl_add_u32 v97, v125, 4, s30
    v_mov_b32 v98, 1
    v_lshlrev_b32 v99, 2, v127
    global_load_dwordx4 v[8:11], v2, s[26:27] offset:0 sc1
    global_load_dwordx4 v[12:15], v2, s[26:27] offset:128 sc1
    global_load_dwordx4 v[16:19], v2, s[26:27] offset:256 sc1
    global_load_dwordx4 v[20:23], v2, s[26:27] offset:384 sc1
    s_waitcnt vmcnt(0) lgkmcnt(0)
    s_barrier
    s_branch L_ROUND
L_EPI:
    s_cmp_ge_u32 s3, 5
    s_cbranch_scc1 L_FIN
    s_mov_b32 s36, 0x538637bd
    v_add_f32 v32, s36, v32
    v_rcp_f32 v32, v32
    v_add_f32 v36, s36, v36
    v_rcp_f32 v36, v36
    v_add_f32 v33, s36, v33
    v_rcp_f32 v33, v33
    v_add_f32 v37, s36, v37
    v_rcp_f32 v37, v37
    v_add_f32 v34, s36, v34
    v_rcp_f32 v34, v34
    v_add_f32 v38, s36, v38
    v_rcp_f32 v38, v38
    v_add_f32 v35, s36, v35
    v_rcp_f32 v35, v35
    v_add_f32 v39, s36, v39
    v_rcp_f32 v39, v39
    v_lshlrev_b32 v8, 16, v112
    v_and_b32 v9, 0xffff0000, v112
    v_lshlrev_b32 v10, 16, v113
    v_and_b32 v11, 0xffff0000, v113
    v_lshlrev_b32 v12, 16, v114
    v_and_b32 v13, 0xffff0000, v114
    v_lshlrev_b32 v14, 16, v115
    v_and_b32 v15, 0xffff0000, v115
    v_fma_f32 v40, v24, v32, v40
    v_fma_f32 v41, v28, v36, v41
    v_fma_f32 v42, v25, v33, v42
    v_fma_f32 v43, v29, v37, v43
    v_fma_f32 v44, v26, v34, v44
    v_fma_f32 v45, v30, v38, v45
    v_fma_f32 v46, v27, v35, v46
    v_fma_f32 v47, v31, v39, v47
    v_cmp_lt_f32 s[48:49], 0, v40
    v_mul_f32 v16, 0, v40
    v_cmp_lt_f32 s[50:51], 0, v41
    v_mul_f32 v17, 0, v41
    v_cmp_lt_f32 s[52:53], 0, v42
    v_mul_f32 v18, 0, v42
    v_cmp_lt_f32 s[54:55], 0, v43
    v_mul_f32 v19, 0, v43
    v_cmp_lt_f32 s[56:57], 0, v44
    v_mul_f32 v20, 0, v44
    v_cmp_lt_f32 s[58:59], 0, v45
    v_mul_f32 v21, 0, v45
    v_cmp_lt_f32 s[60:61], 0, v46
    v_mul_f32 v22, 0, v46
    v_cmp_lt_f32 s[62:63], 0, v47
    v_mul_f32 v23, 0, v47
    v_cndmask_b32 v40, v16, v40, s[48:49]
    v_cndmask_b32 v41, v17, v41, s[50:51]
    v_cndmask_b32 v42, v18, v42, s[52:53]
    v_cndmask_b32 v43, v19, v43, s[54:55]
    v_cndmask_b32 v44, v20, v44, s[56:57]
    v_cndmask_b32 v45, v21, v45, s[58:59]
    v_cndmask_b32 v46, v22, v46, s[60:61]
    v_cndmask_b32 v47, v23, v47, s[62:63]
    v_add_f32 v40, v8, v40
    v_add_f32 v41, v9, v41
    v_add_f32 v42, v10, v42
    v_add_f32 v43, v11, v43
    v_add_f32 v44, v12, v44
    v_add_f32 v45, v13, v45
    v_add_f32 v46, v14, v46
    v_add_f32 v47, v15, v47
    v_cvt_pk_bf16_f32 v16, v40, v41
    v_cvt_pk_bf16_f32 v17, v42, v43
    v_cvt_pk_bf16_f32 v18, v44, v45
    v_cvt_pk_bf16_f32 v19, v46, v47
    v_lshlrev_b32 v4, 4, v0
    s_mul_i32 s36, s2, 5120
    v_add_u32 v4, s36, v4
    global_store_dwordx4 v4, v[16:19], s[22:23] sc1
    s_or_b32 s36, s2, s3
    s_cmp_lg_u32 s36, 0
    s_cbranch_scc1 L_FIN
    v_mov_b32 v4, 0
    v_mov_b32 v6, s28
    v_mov_b32 v7, s29
    s_mov_b64 exec, 1
    global_store_dwordx2 v4, v[6:7], s[26:27] sc1
L_FIN:
L_END:
    s_endpgm
L_CODE_END:

.section .rodata,"a"
.p2align 6
.amdhsa_kernel standalone__edge_featured_mpnn_gatedgcn__graph_kernel
  .amdhsa_next_free_vgpr 128
  .amdhsa_next_free_sgpr 88
  .amdhsa_accum_offset 128
  .amdhsa_group_segment_fixed_size 0
  .amdhsa_kernarg_size 96
  .amdhsa_user_sgpr_count 2
  .amdhsa_user_sgpr_kernarg_segment_ptr 1
  .amdhsa_system_sgpr_workgroup_id_x 1
  .amdhsa_float_denorm_mode_32 3
  .amdhsa_dx10_clamp 0
.end_amdhsa_kernel
```
